```python
import torch

def _softmax(x, axis=-1):
    return torch.softmax(x, dim=axis)
def _gelu(x):
    return torch.nn.functional.gelu(x, approximate="tanh")
def _silu(x):
    return torch.nn.functional.silu(x)
def _sigmoid(x):
    return torch.sigmoid(x)
def _layernorm(x, axis=-1, eps=1e-5):
    m = x.mean(dim=axis, keepdim=True)
    v = x.var(dim=axis, keepdim=True, unbiased=False)
    return (x - m) / torch.sqrt(v + eps)
def _scatter_add(tgt, idx, src, axis=0):
    return tgt.clone().index_add_(axis, idx, src)
def _segment_sum(src, seg, n):
    out = torch.zeros((n,) + src.shape[1:], dtype=src.dtype)
    return out.index_add_(0, seg, src)
def _pad(x, pw):
    flat = tuple(v for pair in reversed(pw) for v in pair)
    return torch.nn.functional.pad(x, flat)

kernel_name = 'standalone__moe_arch_mod__sampling'

def setup_inputs():

    _w = (lambda a: (lambda t: t.to(torch.bfloat16) if t.is_floating_point() else t)(torch.as_tensor(a)))
    B, S, D, F, C = 8, 32, 1024, 3584, 1
    return {
        "x": _w((lambda *s: torch.randn(*s, dtype=torch.bfloat16) * 0.1)(B, S, D)),
        "w_r": _w((lambda *s: torch.randn(*s, dtype=torch.bfloat16) * 0.1)(D)),
        "w_gate": _w((lambda *s: torch.randn(*s, dtype=torch.bfloat16) * 0.1)(D, F)),
        "w_up": _w((lambda *s: torch.randn(*s, dtype=torch.bfloat16) * 0.1)(D, F)),
        "w_down": _w((lambda *s: torch.randn(*s, dtype=torch.bfloat16) * 0.1)(F, D)),
    }

def reference(x, w_r, w_gate, w_up, w_down):
    B, S, D = x.shape
    C = 1
    r = x @ w_r
    idx = torch.argsort(-r, axis=-1)[:, :C]
    idx_e = (lambda x, n, axis: torch.repeat_interleave(x, n, dim=axis))(idx.reshape(B, C, 1), D, axis=2)
    x_sel = (lambda x, i, axis: torch.take_along_dim(x, i, dim=axis))(x, idx_e, axis=1)
    g = _silu(x_sel @ w_gate)
    u = x_sel @ w_up
    y = (g * u) @ w_down
    r_sel = _sigmoid((lambda x, i, axis: torch.take_along_dim(x, i, dim=axis))(r, idx, axis=1))
    y = y * r_sel.reshape(B, C, 1)
    b_off = (torch.arange(B) * S).reshape(B, 1)
    flat_idx = (idx + b_off).reshape(B * C)
    zero = (x * 0.0).reshape(B * S, D)
    upd = _scatter_add(zero, flat_idx, y.reshape(B * C, D), axis=0)
    return x + upd.reshape(B, S, D)
```

```asm
; @launch grid=(256,1,1) block=(384,1,1) lds=17472
.amdgcn_target "amdgcn-amd-amdhsa--gfx950"
.text
.globl standalone__moe_arch_mod__sampling_kernel
.p2align 12
.fill 832, 4, 0xbf800000
.p2align 8
.type standalone__moe_arch_mod__sampling_kernel,@function
standalone__moe_arch_mod__sampling_kernel:
  s_cmp_ge_u32 s2, 256
  s_cbranch_scc1 L_exit
  s_load_dwordx16 s[4:19], s[0:1], 0
  v_lshrrev_b32 v1, 6, v0
  v_and_b32 v0, 63, v0
  v_readfirstlane_b32 s3, v1
  s_lshl_b32 s22, s2, 2
  s_lshr_b32 s22, 0x36542107, s22
  s_and_b32 s22, s22, 7
  s_lshr_b32 s23, s2, 3
  s_lshr_b32 s44, s23, 2
  s_mul_i32 s45, s22, 6
  s_add_u32 s45, s45, s44
  s_add_u32 s44, s45, 4
  s_mul_i32 s44, s44, 37
  s_lshr_b32 s44, s44, 8
  s_add_u32 s20, s45, s44
  s_lshl_b32 s44, s22, 3
  s_add_u32 s44, s44, 3
  s_min_u32 s44, s44, 55
  s_cmp_ge_u32 s23, 24
  s_cselect_b32 s20, s44, s20
  s_cselect_b32 s57, 1, 0
  s_cselect_b32 s21, 7, 3
  s_and_b32 s21, s21, s23
  s_cmp_ge_u32 s23, 26
  s_cselect_b32 s58, 1, 0
  s_mov_b32 s27, 0x20000
  s_cmp_lt_u32 s3, 4
  s_cbranch_scc1 L_c
  s_mov_b32 s30, 524288
  s_mov_b32 s31, 0x20000
  v_lshlrev_b32 v14, 4, v0
  s_cmp_eq_u32 s58, 1
  s_cbranch_scc1 L_rt
  s_cmp_eq_u32 s3, 4
  s_cbranch_scc1 L_r
L_exit:
  s_endpgm
L_rt:
  s_setprio 3
  s_mul_i32 s52, s22, 6
  s_add_u32 s52, s52, s21
  s_lshl_b32 s52, s52, 1
  s_add_u32 s52, s52, s3
  s_sub_u32 s52, s52, 8
  s_and_b32 s52, s52, 63
  s_lshl_b32 s44, s52, 13
  s_add_u32 s45, s44, 4096
  s_movk_i32 s26, 2048
  s_waitcnt lgkmcnt(0)
  s_mov_b64 s[28:29], s[4:5]
  s_mov_b64 s[24:25], s[6:7]
  s_load_dword s40, s[18:19], 0
  buffer_load_dwordx4 v[16:19], v14, s[24:27], 0 offen
  buffer_load_dwordx4 v[20:23], v14, s[24:27], 0 offen offset:1024
  buffer_load_dwordx4 v[80:83], v14, s[28:31], s44 offen offset:0
  buffer_load_dwordx4 v[84:87], v14, s[28:31], s44 offen offset:1024
  buffer_load_dwordx4 v[88:91], v14, s[28:31], s44 offen offset:2048
  buffer_load_dwordx4 v[92:95], v14, s[28:31], s44 offen offset:3072
  buffer_load_dwordx4 v[96:99], v14, s[28:31], s45 offen offset:0
  buffer_load_dwordx4 v[100:103], v14, s[28:31], s45 offen offset:1024
  buffer_load_dwordx4 v[104:107], v14, s[28:31], s45 offen offset:2048
  buffer_load_dwordx4 v[108:111], v14, s[28:31], s45 offen offset:3072
  s_barrier
  s_branch L_route
L_c:
  v_mov_b32 v4, 0
  v_mov_b32 v5, 0
  ds_write_b64 v4, v[4:5] offset:17440
  s_mov_b32 s26, 7340032
  v_lshrrev_b32 v1, 4, v0
  v_and_b32 v2, 15, v0
  v_mul_u32_u24 v3, 57344, v1
  v_lshl_add_u32 v3, v2, 3, v3
  s_lshr_b32 s44, s21, 1
  s_lshl_b32 s44, s44, 2
  s_add_u32 s44, s44, s3
  s_lshr_b32 s45, 917504, s57
  s_mul_i32 s44, s44, s45
  s_lshl_b32 s45, s20, 7
  s_add_u32 s44, s44, s45
  s_bitcmp1_b32 s21, 0
  s_waitcnt lgkmcnt(0)
  s_cselect_b64 s[24:25], s[10:11], s[8:9]
  s_cmp_eq_u32 s58, 0
  s_cbranch_scc1 L_nb0
  s_barrier
L_nb0:
  buffer_load_dwordx2 v[16:17], v3, s[24:27], s44 offen nt
  s_addk_i32 s44, 7168
  buffer_load_dwordx2 v[18:19], v3, s[24:27], s44 offen nt
  s_addk_i32 s44, 7168
  buffer_load_dwordx2 v[20:21], v3, s[24:27], s44 offen nt
  s_addk_i32 s44, 7168
  buffer_load_dwordx2 v[22:23], v3, s[24:27], s44 offen nt
  s_addk_i32 s44, 7168
  buffer_load_dwordx2 v[24:25], v3, s[24:27], s44 offen nt
  s_addk_i32 s44, 7168
  buffer_load_dwordx2 v[26:27], v3, s[24:27], s44 offen nt
  s_addk_i32 s44, 7168
  s_load_dword s40, s[18:19], 0
  s_mov_b64 s[32:33], s[18:19]
  s_mov_b32 s34, 5242880
  s_mov_b32 s35, 0x20000
  s_mov_b32 s42, 0x05040100
  s_mov_b32 s43, 0x07060302
  v_and_b32 v8, 7, v0
  v_lshl_add_u32 v13, v1, 3, v8
  v_lshlrev_b32 v13, 4, v13
  s_lshl_b32 s45, s3, 11
  v_add_u32 v4, s45, v13
  s_lshr_b32 s45, s45, s57
  v_add_u32 v5, s45, v13
  v_lshlrev_b32 v6, 3, v0
  s_lshl_b32 s45, s3, 9
  v_add_u32 v6, s45, v6
  v_lshrrev_b32 v7, 1, v0
  v_lshlrev_b32 v7, 4, v7
  v_and_b32 v9, 1, v0
  v_lshl_add_u32 v7, v9, 2, v7
  s_lshr_b32 s45, s3, 1
  s_lshl_b32 s45, s45, 9
  s_and_b32 s46, s3, 1
  s_lshl_b32 s46, s46, 3
  s_add_u32 s45, s45, s46
  v_add_u32 v7, s45, v7
  s_mov_b64 s[28:29], s[12:13]
  s_mov_b32 s30, 7340032
  s_mov_b32 s31, 0x20000
  v_lshlrev_b32 v10, 15, v1
  v_lshl_add_u32 v10, v2, 3, v10
  v_lshrrev_b32 v11, 3, v2
  v_lshl_add_u32 v11, v1, 7, v11
  v_mul_u32_u24 v11, 8192, v11
  v_lshl_add_u32 v11, v8, 4, v11
  s_lshl_b32 s53, s21, 2
  s_lshr_b32 s53, s53, s57
  s_add_u32 s53, s53, s3
  s_lshr_b32 s45, s3, 1
  s_and_b32 s45, s45, s57
  s_lshl_b32 s45, s45, 30
  v_or_b32 v10, s45, v10
  v_or_b32 v11, s45, v11
  s_mul_i32 s52, s53, 16384
  s_lshl_b32 s46, s20, 7
  s_add_u32 s52, s52, s46
  s_add_u32 s52, s52, 1048576
  s_lshl_b32 s53, s53, 7
  s_lshl_b32 s46, s20, 17
  s_add_u32 s53, s53, s46
  s_lshl_b32 s45, s20, 14
  s_lshl_b32 s46, s21, 11
  s_add_u32 s45, s45, 131072
  s_add_u32 s46, s46, s45
  s_mov_b32 s48, 0xffffff00
  s_mov_b32 s50, 0xbfb8aa3b
  s_mov_b32 s51, 0xbfb8aa3b
  s_mov_b32 s49, 0
  s_getreg_b32 s54, hwreg(HW_REG_XCC_ID, 0, 3)
  v_mov_b32 v12, 1
  v_cmp_eq_u32 vcc, s57, v12
  s_cmp_eq_u32 s58, 1
  s_cbranch_scc1 L_cb
  s_waitcnt vmcnt(5)
  buffer_load_dwordx2 v[28:29], v3, s[24:27], s44 offen nt
  s_addk_i32 s44, 7168
  ds_write_b32 v12, v12 offset:17439
  buffer_load_dwordx2 v[30:31], v3, s[24:27], s44 offen nt
  s_add_u32 s44, s44, 179200
  s_waitcnt vmcnt(6)
  buffer_load_dwordx2 v[32:33], v3, s[24:27], s44 offen nt
  s_addk_i32 s44, 7168
  buffer_load_dwordx2 v[34:35], v3, s[24:27], s44 offen nt
  s_addk_i32 s44, 7168
  s_waitcnt vmcnt(7)
  buffer_load_dwordx2 v[36:37], v3, s[24:27], s44 offen nt
  s_addk_i32 s44, 7168
  buffer_load_dwordx2 v[38:39], v3, s[24:27], s44 offen nt
  s_addk_i32 s44, 7168
  s_waitcnt vmcnt(8)
  buffer_load_dwordx2 v[40:41], v3, s[24:27], s44 offen nt
  s_addk_i32 s44, 7168
  buffer_load_dwordx2 v[42:43], v3, s[24:27], s44 offen nt
  s_addk_i32 s44, 7168
  s_waitcnt vmcnt(9)
  buffer_load_dwordx2 v[44:45], v3, s[24:27], s44 offen nt
  s_addk_i32 s44, 7168
  buffer_load_dwordx2 v[46:47], v3, s[24:27], s44 offen nt
  s_add_u32 s44, s44, 179200
  s_waitcnt vmcnt(10)
  s_cbranch_vccnz L_cc
  buffer_load_dwordx2 v[48:49], v3, s[24:27], s44 offen nt
  s_addk_i32 s44, 7168
  s_waitcnt vmcnt(10)
  buffer_load_dwordx2 v[50:51], v3, s[24:27], s44 offen nt
  s_addk_i32 s44, 7168
  s_waitcnt vmcnt(10)
  buffer_load_dwordx2 v[52:53], v3, s[24:27], s44 offen nt
  s_addk_i32 s44, 7168
  v_perm_b32 v80, v18, v16, s42
  v_perm_b32 v84, v18, v16, s43
  v_perm_b32 v88, v19, v17, s42
  v_perm_b32 v92, v19, v17, s43
  v_perm_b32 v81, v22, v20, s42
  v_perm_b32 v85, v22, v20, s43
  v_perm_b32 v89, v23, v21, s42
  v_perm_b32 v93, v23, v21, s43
  v_perm_b32 v82, v26, v24, s42
  v_perm_b32 v86, v26, v24, s43
  v_perm_b32 v90, v27, v25, s42
  v_perm_b32 v94, v27, v25, s43
  v_perm_b32 v83, v30, v28, s42
  v_perm_b32 v87, v30, v28, s43
  v_perm_b32 v91, v31, v29, s42
  v_perm_b32 v95, v31, v29, s43
  s_waitcnt vmcnt(10)
  buffer_load_dwordx2 v[54:55], v3, s[24:27], s44 offen nt
  s_addk_i32 s44, 7168
  s_waitcnt vmcnt(10)
  buffer_load_dwordx2 v[56:57], v3, s[24:27], s44 offen nt
  s_addk_i32 s44, 7168
  s_waitcnt vmcnt(10)
  buffer_load_dwordx2 v[58:59], v3, s[24:27], s44 offen nt
  s_addk_i32 s44, 7168
  s_waitcnt vmcnt(10)
  buffer_load_dwordx2 v[60:61], v3, s[24:27], s44 offen nt
  s_addk_i32 s44, 7168
  s_waitcnt vmcnt(10)
  buffer_load_dwordx2 v[62:63], v3, s[24:27], s44 offen nt
  s_add_u32 s44, s44, 179200
  s_waitcnt vmcnt(10)
  buffer_load_dwordx2 v[64:65], v3, s[24:27], s44 offen nt
  s_addk_i32 s44, 7168
  s_waitcnt vmcnt(10)
  buffer_load_dwordx2 v[66:67], v3, s[24:27], s44 offen nt
  s_addk_i32 s44, 7168
  s_waitcnt vmcnt(10)
  buffer_load_dwordx2 v[68:69], v3, s[24:27], s44 offen nt
  s_addk_i32 s44, 7168
  v_perm_b32 v16, v34, v32, s42
  v_perm_b32 v20, v34, v32, s43
  v_perm_b32 v24, v35, v33, s42
  v_perm_b32 v28, v35, v33, s43
  v_perm_b32 v17, v38, v36, s42
  v_perm_b32 v21, v38, v36, s43
  v_perm_b32 v25, v39, v37, s42
  v_perm_b32 v29, v39, v37, s43
  v_perm_b32 v18, v42, v40, s42
  v_perm_b32 v22, v42, v40, s43
  v_perm_b32 v26, v43, v41, s42
  v_perm_b32 v30, v43, v41, s43
  v_perm_b32 v19, v46, v44, s42
  v_perm_b32 v23, v46, v44, s43
  v_perm_b32 v27, v47, v45, s42
  v_perm_b32 v31, v47, v45, s43
  s_waitcnt vmcnt(10)
  buffer_load_dwordx2 v[70:71], v3, s[24:27], s44 offen nt
  s_addk_i32 s44, 7168
  s_waitcnt vmcnt(10)
  buffer_load_dwordx2 v[72:73], v3, s[24:27], s44 offen nt
  s_addk_i32 s44, 7168
  s_waitcnt vmcnt(10)
  buffer_load_dwordx2 v[74:75], v3, s[24:27], s44 offen nt
  s_addk_i32 s44, 7168
  s_waitcnt vmcnt(10)
  buffer_load_dwordx2 v[76:77], v3, s[24:27], s44 offen nt
  s_addk_i32 s44, 7168
  s_waitcnt vmcnt(10)
  buffer_load_dwordx2 v[78:79], v3, s[24:27], s44 offen nt
  s_add_u32 s44, s44, 179200
  s_waitcnt vmcnt(10)
  s_add_u32 s47, s53, 0
  buffer_load_dwordx2 v[128:129], v10, s[28:31], s47 offen nt
  s_waitcnt vmcnt(10)
  s_add_u32 s47, s53, 8192
  buffer_load_dwordx2 v[130:131], v10, s[28:31], s47 offen nt
  s_waitcnt vmcnt(10)
  s_add_u32 s47, s53, 16384
  buffer_load_dwordx2 v[132:133], v10, s[28:31], s47 offen nt
  v_perm_b32 v32, v50, v48, s42
  v_perm_b32 v36, v50, v48, s43
  v_perm_b32 v40, v51, v49, s42
  v_perm_b32 v44, v51, v49, s43
  v_perm_b32 v33, v54, v52, s42
  v_perm_b32 v37, v54, v52, s43
  v_perm_b32 v41, v55, v53, s42
  v_perm_b32 v45, v55, v53, s43
  v_perm_b32 v34, v58, v56, s42
  v_perm_b32 v38, v58, v56, s43
  v_perm_b32 v42, v59, v57, s42
  v_perm_b32 v46, v59, v57, s43
  v_perm_b32 v35, v62, v60, s42
  v_perm_b32 v39, v62, v60, s43
  v_perm_b32 v43, v63, v61, s42
  v_perm_b32 v47, v63, v61, s43
  s_waitcnt vmcnt(10)
  s_add_u32 s47, s53, 24576
  buffer_load_dwordx2 v[134:135], v10, s[28:31], s47 offen nt
  s_waitcnt vmcnt(10)
  s_add_u32 s47, s53, 2048
  buffer_load_dwordx2 v[136:137], v10, s[28:31], s47 offen nt
  s_waitcnt vmcnt(10)
  s_add_u32 s47, s53, 10240
  buffer_load_dwordx2 v[138:139], v10, s[28:31], s47 offen nt
  s_waitcnt vmcnt(10)
  s_add_u32 s47, s53, 18432
  buffer_load_dwordx2 v[140:141], v10, s[28:31], s47 offen nt
  s_barrier
  s_add_u32 s47, s53, 26624
  buffer_load_dwordx2 v[142:143], v10, s[28:31], s47 offen nt
  s_add_u32 s47, s53, 4096
  buffer_load_dwordx2 v[144:145], v10, s[28:31], s47 offen nt
  s_add_u32 s47, s53, 12288
  buffer_load_dwordx2 v[146:147], v10, s[28:31], s47 offen nt
  s_add_u32 s47, s53, 20480
  buffer_load_dwordx2 v[148:149], v10, s[28:31], s47 offen nt
  s_add_u32 s47, s53, 28672
  buffer_load_dwordx2 v[150:151], v10, s[28:31], s47 offen nt
  s_add_u32 s47, s53, 6144
  buffer_load_dwordx2 v[152:153], v10, s[28:31], s47 offen nt
  s_add_u32 s47, s53, 14336
  buffer_load_dwordx2 v[154:155], v10, s[28:31], s47 offen nt
  s_add_u32 s47, s53, 22528
  buffer_load_dwordx2 v[156:157], v10, s[28:31], s47 offen nt
  s_add_u32 s47, s53, 30720
  buffer_load_dwordx2 v[158:159], v10, s[28:31], s47 offen nt
  s_waitcnt lgkmcnt(0)
  s_add_u32 s40, s40, 8
  s_and_b32 s41, s40, 0xff
  s_and_b32 s55, s40, 0xf8
  s_or_b32 s54, s54, s55
  v_mov_b32 v9, s41
  v_mov_b32 v12, s54
  s_bitcmp1_b32 s21, 0
  s_cselect_b64 s[22:23], -1, 0
  s_xor_b32 s76, s46, 2048
  s_xor_b32 s77, s46, 4096
  s_xor_b32 s78, s46, 6144
  s_add_u32 s84, s52, 262144
  s_add_u32 s85, s52, 524288
  s_add_u32 s86, s52, 786432
  s_waitcnt vmcnt(18)
  v_perm_b32 v48, v66, v64, s42
  v_perm_b32 v52, v66, v64, s43
  v_perm_b32 v56, v67, v65, s42
  v_perm_b32 v60, v67, v65, s43
  v_perm_b32 v49, v70, v68, s42
  v_perm_b32 v53, v70, v68, s43
  v_perm_b32 v57, v71, v69, s42
  v_perm_b32 v61, v71, v69, s43
  v_perm_b32 v50, v74, v72, s42
  v_perm_b32 v54, v74, v72, s43
  v_perm_b32 v58, v75, v73, s42
  v_perm_b32 v62, v75, v73, s43
  s_barrier
  ds_read_b128 v[96:99], v5 offset:0
  ds_read_b128 v[100:103], v5 offset:512
  ds_read_b128 v[104:107], v5 offset:1024
  ds_read_b128 v[108:111], v5 offset:1536
  s_waitcnt lgkmcnt(3)
  v_mfma_f32_16x16x32_bf16 v[112:115], v[80:83], v[96:99], 0
  v_mfma_f32_16x16x32_bf16 v[116:119], v[84:87], v[96:99], 0
  v_mfma_f32_16x16x32_bf16 v[120:123], v[88:91], v[96:99], 0
  v_mfma_f32_16x16x32_bf16 v[124:127], v[92:95], v[96:99], 0
  s_waitcnt lgkmcnt(2)
  v_mfma_f32_16x16x32_bf16 v[112:115], v[16:19], v[100:103], v[112:115]
  v_mfma_f32_16x16x32_bf16 v[116:119], v[20:23], v[100:103], v[116:119]
  v_mfma_f32_16x16x32_bf16 v[120:123], v[24:27], v[100:103], v[120:123]
  v_mfma_f32_16x16x32_bf16 v[124:127], v[28:31], v[100:103], v[124:127]
  s_waitcnt lgkmcnt(1)
  v_mfma_f32_16x16x32_bf16 v[112:115], v[32:35], v[104:107], v[112:115]
  v_mfma_f32_16x16x32_bf16 v[116:119], v[36:39], v[104:107], v[116:119]
  v_mfma_f32_16x16x32_bf16 v[120:123], v[40:43], v[104:107], v[120:123]
  v_mfma_f32_16x16x32_bf16 v[124:127], v[44:47], v[104:107], v[124:127]
  s_waitcnt vmcnt(16)
  v_perm_b32 v51, v78, v76, s42
  v_perm_b32 v55, v78, v76, s43
  v_perm_b32 v59, v79, v77, s42
  v_perm_b32 v63, v79, v77, s43
  s_nop 0
  s_waitcnt lgkmcnt(0)
  v_mfma_f32_16x16x32_bf16 v[112:115], v[48:51], v[108:111], v[112:115]
  v_mfma_f32_16x16x32_bf16 v[116:119], v[52:55], v[108:111], v[116:119]
  v_mfma_f32_16x16x32_bf16 v[120:123], v[56:59], v[108:111], v[120:123]
  v_mfma_f32_16x16x32_bf16 v[124:127], v[60:63], v[108:111], v[124:127]
  s_mov_b32 exec_lo, 0x00ff00ff
  s_mov_b32 exec_hi, 0x00ff00ff
  s_nop 2
  ds_write_b128 v4, v[112:115] offset:8192
  ds_write_b128 v4, v[116:119] offset:8704
  ds_write_b128 v4, v[120:123] offset:9216
  ds_write_b128 v4, v[124:127] offset:9728
  s_mov_b64 exec, -1
  s_waitcnt lgkmcnt(0)
  s_barrier
  ds_read2st64_b64 v[16:19], v6 offset0:16 offset1:20
  ds_read2st64_b64 v[20:23], v6 offset0:24 offset1:28
  s_waitcnt lgkmcnt(1)
  v_pk_add_f32 v[16:17], v[16:17], v[18:19]
  s_waitcnt lgkmcnt(0)
  v_pk_add_f32 v[20:21], v[20:21], v[22:23]
  v_pk_add_f32 v[16:17], v[16:17], v[20:21]
  v_and_or_b32 v16, v16, s48, v12
  buffer_store_dwordx2 v[16:17], v6, s[32:35], s46 offen
  s_waitcnt vmcnt(3)
  buffer_load_dwordx2 v[26:27], v6, s[32:35], s76 offen sc1
  buffer_load_dwordx2 v[28:29], v6, s[32:35], s77 offen sc1
  buffer_load_dwordx2 v[30:31], v6, s[32:35], s78 offen sc1
  v_and_b32 v24, s48, v16
  v_mov_b32 v25, v17
  v_perm_b32 v40, v130, v128, s42
  v_perm_b32 v44, v130, v128, s43
  v_perm_b32 v48, v131, v129, s42
  v_perm_b32 v52, v131, v129, s43
  v_perm_b32 v41, v134, v132, s42
  v_perm_b32 v45, v134, v132, s43
  v_perm_b32 v49, v135, v133, s42
  v_perm_b32 v53, v135, v133, s43
  v_perm_b32 v42, v138, v136, s42
  v_perm_b32 v46, v138, v136, s43
  v_perm_b32 v50, v139, v137, s42
  v_perm_b32 v54, v139, v137, s43
  v_perm_b32 v43, v142, v140, s42
  v_perm_b32 v47, v142, v140, s43
  v_perm_b32 v51, v143, v141, s42
  v_perm_b32 v55, v143, v141, s43
  v_perm_b32 v56, v146, v144, s42
  v_perm_b32 v60, v146, v144, s43
  v_perm_b32 v64, v147, v145, s42
  v_perm_b32 v68, v147, v145, s43
  v_perm_b32 v57, v150, v148, s42
  v_perm_b32 v61, v150, v148, s43
  v_perm_b32 v65, v151, v149, s42
  v_perm_b32 v69, v151, v149, s43
  v_perm_b32 v58, v154, v152, s42
  v_perm_b32 v62, v154, v152, s43
  v_perm_b32 v66, v155, v153, s42
  v_perm_b32 v70, v155, v153, s43
  s_branch L_x1chka
L_x1rea:
  s_cmp_ge_u32 s49, 12
  s_cbranch_scc1 L_x1noa
L_x1polla:
  buffer_load_dwordx2 v[26:27], v6, s[32:35], s76 offen sc1
  buffer_load_dwordx2 v[28:29], v6, s[32:35], s77 offen sc1
  buffer_load_dwordx2 v[30:31], v6, s[32:35], s78 offen sc1
L_x1chka:
  s_add_u32 s49, s49, 1
  s_waitcnt vmcnt(0)
  v_xor_b32 v26, s54, v26
  v_xor_b32 v28, s54, v28
  v_xor_b32 v30, s54, v30
  v_or3_b32 v8, v26, v28, v30
  v_cmp_ne_u32_sdwa vcc, v8, 0 src0_sel:BYTE_0 src1_sel:DWORD
  s_cbranch_vccnz L_x1rea
L_x1oka:
L_h:
  v_pk_add_f32 v[24:25], v[24:25], v[28:29]
  v_pk_add_f32 v[26:27], v[26:27], v[30:31]
  v_cvt_pk_bf16_f32 v24, 0, v24
  v_cvt_pk_bf16_f32 v25, 0, v25
  v_cvt_pk_bf16_f32 v26, 0, v26
  v_cvt_pk_bf16_f32 v27, 0, v27
  v_cndmask_b32 v18, v24, v26, s[22:23]
  v_cndmask_b32 v19, v25, v27, s[22:23]
  v_pk_mul_f32 v[20:21], v[18:19], s[50:51]
  v_exp_f32 v20, v20
  v_exp_f32 v21, v21
  v_cndmask_b32 v14, v26, v24, s[22:23]
  v_pk_add_f32 v[20:21], v[20:21], 1.0 op_sel_hi:[1,0]
  v_rcp_f32 v20, v20
  v_rcp_f32 v21, v21
  v_cndmask_b32 v15, v27, v25, s[22:23]
  v_pk_mul_f32 v[18:19], v[18:19], v[20:21]
  v_cvt_pk_bf16_f32 v18, 0, v18
  v_cvt_pk_bf16_f32 v19, 0, v19
  v_pk_mul_f32 v[18:19], v[18:19], v[14:15]
  v_cvt_pk_bf16_f32 v8, v18, v19
  ds_write_b32 v7, v8 offset:16384
  v_perm_b32 v59, v158, v156, s42
  v_perm_b32 v63, v158, v156, s43
  v_perm_b32 v67, v159, v157, s42
  v_perm_b32 v71, v159, v157, s43
  s_waitcnt lgkmcnt(0)
  s_barrier
  ds_read_b128 v[72:75], v13 offset:16384
  ds_read_b128 v[76:79], v13 offset:16896
  s_waitcnt lgkmcnt(1)
  v_mfma_f32_16x16x32_bf16 v[112:115], v[72:75], v[40:43], 0
  v_mfma_f32_16x16x32_bf16 v[116:119], v[72:75], v[44:47], 0
  v_mfma_f32_16x16x32_bf16 v[120:123], v[72:75], v[48:51], 0
  v_mfma_f32_16x16x32_bf16 v[124:127], v[72:75], v[52:55], 0
  s_waitcnt lgkmcnt(0)
  v_mfma_f32_16x16x32_bf16 v[112:115], v[76:79], v[56:59], v[112:115]
  v_mfma_f32_16x16x32_bf16 v[116:119], v[76:79], v[60:63], v[116:119]
  v_mfma_f32_16x16x32_bf16 v[120:123], v[76:79], v[64:67], v[120:123]
  v_mfma_f32_16x16x32_bf16 v[124:127], v[76:79], v[68:71], v[124:127]
  s_mov_b32 exec_lo, -1
  s_mov_b32 exec_hi, 0
  s_nop 2
  v_and_or_b32 v20, v112, s48, v9
  v_mov_b32 v21, v116
  v_and_or_b32 v22, v120, s48, v9
  v_mov_b32 v23, v124
  buffer_store_dwordx4 v[20:23], v11, s[32:35], s52 offen sc1
  v_and_or_b32 v24, v113, s48, v9
  v_mov_b32 v25, v117
  v_and_or_b32 v26, v121, s48, v9
  v_mov_b32 v27, v125
  buffer_store_dwordx4 v[24:27], v11, s[32:35], s84 offen sc1
  v_and_or_b32 v28, v114, s48, v9
  v_mov_b32 v29, v118
  v_and_or_b32 v30, v122, s48, v9
  v_mov_b32 v31, v126
  buffer_store_dwordx4 v[28:31], v11, s[32:35], s85 offen sc1
  v_and_or_b32 v32, v115, s48, v9
  v_mov_b32 v33, v119
  v_and_or_b32 v34, v123, s48, v9
  v_mov_b32 v35, v127
  buffer_store_dwordx4 v[32:35], v11, s[32:35], s86 offen sc1
  s_endpgm
L_route:
  s_mov_b64 s[32:33], s[18:19]
  s_mov_b32 s34, 5242880
  s_mov_b32 s35, 0x20000
  s_mov_b64 s[36:37], s[14:15]
  s_mov_b32 s38, 524288
  s_mov_b32 s39, 0x20000
  v_and_b32 v4, 7, v0
  s_and_b32 s45, s52, 7
  s_lshl_b32 s46, s45, 3
  s_lshr_b32 s52, s52, 3
  s_add_u32 s46, s46, s52
  s_mul_i32 s46, s46, 8
  s_add_u32 s46, s46, 4096
  s_lshl_b32 s45, s45, 2
  v_lshrrev_b32 v10, 5, v0
  v_bfe_u32 v11, v0, 4, 1
  v_lshl_add_u32 v10, v11, 1, v10
  v_add_u32 v10, s45, v10
  v_xor_b32 v10, 31, v10
  s_waitcnt vmcnt(7)
  v_dot2_f32_bf16 v6, v80, v16, 0
  v_dot2_f32_bf16 v6, v81, v17, v6
  v_dot2_f32_bf16 v6, v82, v18, v6
  v_dot2_f32_bf16 v6, v83, v19, v6
  s_waitcnt vmcnt(6)
  v_dot2_f32_bf16 v6, v84, v20, v6
  v_dot2_f32_bf16 v6, v85, v21, v6
  v_dot2_f32_bf16 v6, v86, v22, v6
  v_dot2_f32_bf16 v6, v87, v23, v6
  s_waitcnt vmcnt(5)
  v_dot2_f32_bf16 v7, v88, v16, 0
  v_dot2_f32_bf16 v7, v89, v17, v7
  v_dot2_f32_bf16 v7, v90, v18, v7
  v_dot2_f32_bf16 v7, v91, v19, v7
  s_waitcnt vmcnt(4)
  v_dot2_f32_bf16 v7, v92, v20, v7
  v_dot2_f32_bf16 v7, v93, v21, v7
  v_dot2_f32_bf16 v7, v94, v22, v7
  v_dot2_f32_bf16 v7, v95, v23, v7
  s_waitcnt vmcnt(3)
  v_dot2_f32_bf16 v8, v96, v16, 0
  v_dot2_f32_bf16 v8, v97, v17, v8
  v_dot2_f32_bf16 v8, v98, v18, v8
  v_dot2_f32_bf16 v8, v99, v19, v8
  s_waitcnt vmcnt(2)
  v_dot2_f32_bf16 v8, v100, v20, v8
  v_dot2_f32_bf16 v8, v101, v21, v8
  v_dot2_f32_bf16 v8, v102, v22, v8
  v_dot2_f32_bf16 v8, v103, v23, v8
  s_waitcnt vmcnt(1)
  v_dot2_f32_bf16 v9, v104, v16, 0
  v_dot2_f32_bf16 v9, v105, v17, v9
  v_dot2_f32_bf16 v9, v106, v18, v9
  v_dot2_f32_bf16 v9, v107, v19, v9
  s_waitcnt vmcnt(0)
  v_dot2_f32_bf16 v9, v108, v20, v9
  v_dot2_f32_bf16 v9, v109, v21, v9
  v_dot2_f32_bf16 v9, v110, v22, v9
  v_dot2_f32_bf16 v9, v111, v23, v9
  s_waitcnt lgkmcnt(0)
  s_add_u32 s40, s40, 8
  s_nop 0
  v_permlane32_swap_b32 v6, v7
  v_permlane32_swap_b32 v8, v9
  v_add_f32 v6, v6, v7
  v_add_f32 v8, v8, v9
  s_nop 1
  v_permlane16_swap_b32 v6, v8
  v_add_f32 v6, v6, v8
  s_nop 1
  v_add_f32_dpp v6, v6, v6 quad_perm:[1,0,3,2] row_mask:0xf bank_mask:0xf
  s_nop 1
  v_add_f32_dpp v6, v6, v6 quad_perm:[2,3,0,1] row_mask:0xf bank_mask:0xf
  s_nop 1
  v_add_f32_dpp v6, v6, v6 row_half_mirror row_mask:0xf bank_mask:0xf
  s_nop 1
  v_add_f32_dpp v6, v6, v6 row_mirror row_mask:0xf bank_mask:0xf
  v_cvt_pk_bf16_f32 v7, v6, v6
  v_and_b32 v7, 0xffff0000, v7
  v_ashrrev_i32 v6, 31, v7
  v_or_b32 v6, 0x80000000, v6
  v_xor_b32 v6, v6, v7
  v_cmp_o_f32 vcc, v7, v7
  v_and_b32 v6, 0xffff0000, v6
  s_nop 0
  v_cndmask_b32 v6, 0, v6, vcc
  v_or_b32 v6, v10, v6
  v_mov_b32 v7, v6
  s_nop 1
  v_permlane16_swap_b32 v6, v7
  v_max_u32 v6, v6, v7
  v_mov_b32 v7, v6
  s_nop 1
  v_permlane32_swap_b32 v6, v7
  v_max_u32 v6, v6, v7
  v_mov_b32 v7, s40
  s_mov_b64 exec, 0x1
  buffer_store_dwordx2 v[6:7], off, s[32:35], s46 sc1
  s_mov_b64 exec, -1
  s_barrier
  s_setprio 0
  s_cmp_eq_u32 s3, 4
  s_cbranch_scc1 L_r4
  s_endpgm
.p2align 12
L_cb:
  s_barrier
  s_waitcnt vmcnt(5)
  buffer_load_dwordx2 v[28:29], v3, s[24:27], s44 offen nt
  s_addk_i32 s44, 7168
  buffer_load_dwordx2 v[30:31], v3, s[24:27], s44 offen nt
  s_add_u32 s44, s44, 179200
  s_waitcnt vmcnt(6)
  buffer_load_dwordx2 v[32:33], v3, s[24:27], s44 offen nt
  s_addk_i32 s44, 7168
  buffer_load_dwordx2 v[34:35], v3, s[24:27], s44 offen nt
  s_addk_i32 s44, 7168
  s_waitcnt vmcnt(7)
  buffer_load_dwordx2 v[36:37], v3, s[24:27], s44 offen nt
  s_addk_i32 s44, 7168
  s_waitcnt vmcnt(7)
  buffer_load_dwordx2 v[38:39], v3, s[24:27], s44 offen nt
  s_addk_i32 s44, 7168
  s_waitcnt vmcnt(7)
  buffer_load_dwordx2 v[40:41], v3, s[24:27], s44 offen nt
  s_addk_i32 s44, 7168
  s_waitcnt vmcnt(7)
  buffer_load_dwordx2 v[42:43], v3, s[24:27], s44 offen nt
  s_addk_i32 s44, 7168
  s_waitcnt vmcnt(7)
  buffer_load_dwordx2 v[44:45], v3, s[24:27], s44 offen nt
  s_addk_i32 s44, 7168
  s_waitcnt vmcnt(7)
  buffer_load_dwordx2 v[46:47], v3, s[24:27], s44 offen nt
  s_add_u32 s44, s44, 179200
  v_perm_b32 v80, v18, v16, s42
  v_perm_b32 v84, v18, v16, s43
  v_perm_b32 v88, v19, v17, s42
  v_perm_b32 v92, v19, v17, s43
  v_perm_b32 v81, v22, v20, s42
  v_perm_b32 v85, v22, v20, s43
  v_perm_b32 v89, v23, v21, s42
  v_perm_b32 v93, v23, v21, s43
  v_perm_b32 v82, v26, v24, s42
  v_perm_b32 v86, v26, v24, s43
  v_perm_b32 v90, v27, v25, s42
  v_perm_b32 v94, v27, v25, s43
  v_perm_b32 v83, v30, v28, s42
  v_perm_b32 v87, v30, v28, s43
  v_perm_b32 v91, v31, v29, s42
  v_perm_b32 v95, v31, v29, s43
  s_add_u32 s47, s53, 0
  buffer_load_dwordx2 v[128:129], v10, s[28:31], s47 offen nt
  s_add_u32 s47, s53, 8192
  buffer_load_dwordx2 v[130:131], v10, s[28:31], s47 offen nt
  s_add_u32 s47, s53, 16384
  buffer_load_dwordx2 v[132:133], v10, s[28:31], s47 offen nt
  s_add_u32 s47, s53, 24576
  buffer_load_dwordx2 v[134:135], v10, s[28:31], s47 offen nt
  s_waitcnt vmcnt(11)
  s_add_u32 s47, s53, 2048
  buffer_load_dwordx2 v[136:137], v10, s[28:31], s47 offen nt
  s_waitcnt vmcnt(11)
  s_add_u32 s47, s53, 10240
  buffer_load_dwordx2 v[138:139], v10, s[28:31], s47 offen nt
  s_waitcnt vmcnt(11)
  s_add_u32 s47, s53, 18432
  buffer_load_dwordx2 v[140:141], v10, s[28:31], s47 offen nt
  s_waitcnt vmcnt(11)
  s_add_u32 s47, s53, 26624
  buffer_load_dwordx2 v[142:143], v10, s[28:31], s47 offen nt
  s_barrier
L_bx:
  s_add_u32 s47, s53, 4096
  buffer_load_dwordx2 v[144:145], v10, s[28:31], s47 offen nt
  s_add_u32 s47, s53, 12288
  buffer_load_dwordx2 v[146:147], v10, s[28:31], s47 offen nt
  s_add_u32 s47, s53, 20480
  buffer_load_dwordx2 v[148:149], v10, s[28:31], s47 offen nt
  s_add_u32 s47, s53, 28672
  buffer_load_dwordx2 v[150:151], v10, s[28:31], s47 offen nt
  s_add_u32 s47, s53, 6144
  buffer_load_dwordx2 v[152:153], v10, s[28:31], s47 offen nt
  s_add_u32 s47, s53, 14336
  buffer_load_dwordx2 v[154:155], v10, s[28:31], s47 offen nt
  s_add_u32 s47, s53, 22528
  buffer_load_dwordx2 v[156:157], v10, s[28:31], s47 offen nt
  s_add_u32 s47, s53, 30720
  buffer_load_dwordx2 v[158:159], v10, s[28:31], s47 offen nt
  s_waitcnt lgkmcnt(0)
  s_add_u32 s40, s40, 8
  s_and_b32 s41, s40, 0xff
  s_and_b32 s55, s40, 0xf8
  s_or_b32 s54, s54, s55
  v_mov_b32 v9, s41
  v_mov_b32 v12, s54
  s_bitcmp1_b32 s21, 0
  s_cselect_b64 s[22:23], -1, 0
  s_xor_b32 s76, s46, 2048
  s_xor_b32 s77, s46, 4096
  s_xor_b32 s78, s46, 6144
  s_xor_b32 s79, s46, 8192
  s_xor_b32 s80, s46, 10240
  s_xor_b32 s81, s46, 12288
  s_xor_b32 s82, s46, 14336
  s_add_u32 s84, s52, 262144
  s_add_u32 s85, s52, 524288
  s_add_u32 s86, s52, 786432
  s_waitcnt vmcnt(16)
  v_perm_b32 v16, v34, v32, s42
  v_perm_b32 v20, v34, v32, s43
  v_perm_b32 v24, v35, v33, s42
  v_perm_b32 v28, v35, v33, s43
  v_perm_b32 v17, v38, v36, s42
  v_perm_b32 v21, v38, v36, s43
  v_perm_b32 v25, v39, v37, s42
  v_perm_b32 v29, v39, v37, s43
  v_perm_b32 v18, v42, v40, s42
  v_perm_b32 v22, v42, v40, s43
  v_perm_b32 v26, v43, v41, s42
  v_perm_b32 v30, v43, v41, s43
  v_perm_b32 v19, v46, v44, s42
  v_perm_b32 v23, v46, v44, s43
  v_perm_b32 v27, v47, v45, s42
  v_perm_b32 v31, v47, v45, s43
  s_barrier
  ds_read_b128 v[96:99], v5 offset:0
  ds_read_b128 v[100:103], v5 offset:512
  s_waitcnt lgkmcnt(1)
  v_mfma_f32_16x16x32_bf16 v[112:115], v[80:83], v[96:99], 0
  v_mfma_f32_16x16x32_bf16 v[116:119], v[84:87], v[96:99], 0
  v_mfma_f32_16x16x32_bf16 v[120:123], v[88:91], v[96:99], 0
  v_mfma_f32_16x16x32_bf16 v[124:127], v[92:95], v[96:99], 0
  s_waitcnt lgkmcnt(0)
  v_mfma_f32_16x16x32_bf16 v[112:115], v[16:19], v[100:103], v[112:115]
  v_mfma_f32_16x16x32_bf16 v[116:119], v[20:23], v[100:103], v[116:119]
  v_mfma_f32_16x16x32_bf16 v[120:123], v[24:27], v[100:103], v[120:123]
  v_mfma_f32_16x16x32_bf16 v[124:127], v[28:31], v[100:103], v[124:127]
  s_mov_b32 exec_lo, 0x00ff00ff
  s_mov_b32 exec_hi, 0x00ff00ff
  s_nop 2
  ds_write_b128 v4, v[112:115] offset:8192
  ds_write_b128 v4, v[116:119] offset:8704
  ds_write_b128 v4, v[120:123] offset:9216
  ds_write_b128 v4, v[124:127] offset:9728
  s_mov_b64 exec, -1
  s_waitcnt lgkmcnt(0)
  s_barrier
  ds_read2st64_b64 v[16:19], v6 offset0:16 offset1:20
  ds_read2st64_b64 v[20:23], v6 offset0:24 offset1:28
  s_waitcnt lgkmcnt(1)
  v_pk_add_f32 v[16:17], v[16:17], v[18:19]
  s_waitcnt lgkmcnt(0)
  v_pk_add_f32 v[20:21], v[20:21], v[22:23]
  v_pk_add_f32 v[16:17], v[16:17], v[20:21]
  v_and_or_b32 v16, v16, s48, v12
  buffer_store_dwordx2 v[16:17], v6, s[32:35], s46 offen
  s_waitcnt vmcnt(3)
  buffer_load_dwordx2 v[26:27], v6, s[32:35], s76 offen sc1
  buffer_load_dwordx2 v[28:29], v6, s[32:35], s77 offen sc1
  buffer_load_dwordx2 v[30:31], v6, s[32:35], s78 offen sc1
  buffer_load_dwordx2 v[32:33], v6, s[32:35], s79 offen sc1
  buffer_load_dwordx2 v[34:35], v6, s[32:35], s80 offen sc1
  buffer_load_dwordx2 v[36:37], v6, s[32:35], s81 offen sc1
  buffer_load_dwordx2 v[38:39], v6, s[32:35], s82 offen sc1
  v_and_b32 v24, s48, v16
  v_mov_b32 v25, v17
  v_perm_b32 v40, v130, v128, s42
  v_perm_b32 v44, v130, v128, s43
  v_perm_b32 v48, v131, v129, s42
  v_perm_b32 v52, v131, v129, s43
  v_perm_b32 v41, v134, v132, s42
  v_perm_b32 v45, v134, v132, s43
  v_perm_b32 v49, v135, v133, s42
  v_perm_b32 v53, v135, v133, s43
  v_perm_b32 v42, v138, v136, s42
  v_perm_b32 v46, v138, v136, s43
  v_perm_b32 v50, v139, v137, s42
  v_perm_b32 v54, v139, v137, s43
  v_perm_b32 v43, v142, v140, s42
  v_perm_b32 v47, v142, v140, s43
  v_perm_b32 v51, v143, v141, s42
  v_perm_b32 v55, v143, v141, s43
  v_perm_b32 v56, v146, v144, s42
  v_perm_b32 v60, v146, v144, s43
  v_perm_b32 v64, v147, v145, s42
  v_perm_b32 v68, v147, v145, s43
  v_perm_b32 v57, v150, v148, s42
  v_perm_b32 v61, v150, v148, s43
  v_perm_b32 v65, v151, v149, s42
  v_perm_b32 v69, v151, v149, s43
  v_perm_b32 v58, v154, v152, s42
  v_perm_b32 v62, v154, v152, s43
  v_perm_b32 v66, v155, v153, s42
  v_perm_b32 v70, v155, v153, s43
  s_branch L_x1chkb
L_x1reb:
  s_cmp_ge_u32 s49, 12
  s_cbranch_scc1 L_x1nob
L_x1pollb:
  buffer_load_dwordx2 v[26:27], v6, s[32:35], s76 offen sc1
  buffer_load_dwordx2 v[28:29], v6, s[32:35], s77 offen sc1
  buffer_load_dwordx2 v[30:31], v6, s[32:35], s78 offen sc1
  buffer_load_dwordx2 v[32:33], v6, s[32:35], s79 offen sc1
  buffer_load_dwordx2 v[34:35], v6, s[32:35], s80 offen sc1
  buffer_load_dwordx2 v[36:37], v6, s[32:35], s81 offen sc1
  buffer_load_dwordx2 v[38:39], v6, s[32:35], s82 offen sc1
L_x1chkb:
  s_add_u32 s49, s49, 1
  s_waitcnt vmcnt(0)
  v_xor_b32 v26, s54, v26
  v_xor_b32 v28, s54, v28
  v_xor_b32 v30, s54, v30
  v_xor_b32 v32, s54, v32
  v_xor_b32 v34, s54, v34
  v_xor_b32 v36, s54, v36
  v_xor_b32 v38, s54, v38
  v_or3_b32 v8, v26, v28, v30
  v_or3_b32 v8, v8, v32, v34
  v_or3_b32 v8, v8, v36, v38
  v_cmp_ne_u32_sdwa vcc, v8, 0 src0_sel:BYTE_0 src1_sel:DWORD
  s_cbranch_vccnz L_x1reb
L_x1okb:
  v_pk_add_f32 v[24:25], v[24:25], v[32:33]
  v_pk_add_f32 v[26:27], v[26:27], v[34:35]
  v_pk_add_f32 v[28:29], v[28:29], v[36:37]
  v_pk_add_f32 v[30:31], v[30:31], v[38:39]
  s_branch L_h
L_cc:
  s_waitcnt vmcnt(8)
  v_perm_b32 v80, v18, v16, s42
  v_perm_b32 v84, v18, v16, s43
  v_perm_b32 v88, v19, v17, s42
  v_perm_b32 v92, v19, v17, s43
  v_perm_b32 v81, v22, v20, s42
  v_perm_b32 v85, v22, v20, s43
  v_perm_b32 v89, v23, v21, s42
  v_perm_b32 v93, v23, v21, s43
  v_perm_b32 v82, v26, v24, s42
  v_perm_b32 v86, v26, v24, s43
  v_perm_b32 v90, v27, v25, s42
  v_perm_b32 v94, v27, v25, s43
  v_perm_b32 v83, v30, v28, s42
  v_perm_b32 v87, v30, v28, s43
  v_perm_b32 v91, v31, v29, s42
  v_perm_b32 v95, v31, v29, s43
  s_waitcnt vmcnt(0)
  ds_write_b32 v12, v12 offset:17443
  s_barrier
  s_add_u32 s47, s53, 0
  buffer_load_dwordx2 v[128:129], v10, s[28:31], s47 offen nt
  s_add_u32 s47, s53, 8192
  buffer_load_dwordx2 v[130:131], v10, s[28:31], s47 offen nt
  s_add_u32 s47, s53, 16384
  buffer_load_dwordx2 v[132:133], v10, s[28:31], s47 offen nt
  s_add_u32 s47, s53, 24576
  buffer_load_dwordx2 v[134:135], v10, s[28:31], s47 offen nt
  s_add_u32 s47, s53, 2048
  buffer_load_dwordx2 v[136:137], v10, s[28:31], s47 offen nt
  s_add_u32 s47, s53, 10240
  buffer_load_dwordx2 v[138:139], v10, s[28:31], s47 offen nt
  s_add_u32 s47, s53, 18432
  buffer_load_dwordx2 v[140:141], v10, s[28:31], s47 offen nt
  s_add_u32 s47, s53, 26624
  buffer_load_dwordx2 v[142:143], v10, s[28:31], s47 offen nt
  s_branch L_bx
L_r:
  s_waitcnt lgkmcnt(0)
  s_load_dword s40, s[18:19], 0
  s_mov_b64 s[28:29], s[4:5]
  s_mov_b64 s[32:33], s[18:19]
  s_mov_b32 s34, 5242880
  s_mov_b32 s35, 0x20000
  s_mov_b64 s[36:37], s[14:15]
  s_mov_b32 s38, 524288
  s_mov_b32 s39, 0x20000
  v_and_b32 v4, 7, v0
L_r4:
  s_lshl_b32 s53, s2, 11
  v_mul_u32_u24 v12, 8, v0
  s_movk_i32 s47, 4096
  v_lshrrev_b32 v11, 3, v0
  s_lshr_b32 s45, s21, 1
  s_sub_u32 s46, 10, s57
  s_lshl_b32 s45, s45, s46
  s_lshl_b32 s48, s20, 14
  s_lshl_b32 s46, s21, 11
  s_add_u32 s48, s48, s46
  s_add_u32 s48, s48, 131072
  s_lshr_b32 s51, s2, 5
  s_getreg_b32 s42, hwreg(HW_REG_XCC_ID, 0, 3)
  v_lshlrev_b32 v13, 3, v0
  s_lshl_b32 s42, s42, 11
  s_add_u32 s42, s42, 73728
  buffer_load_dwordx4 v[16:19], v14, s[32:35], s42 offen offset:0
  buffer_load_dwordx4 v[20:23], v14, s[32:35], s42 offen offset:1024
  s_cmp_eq_u32 s58, 1
  s_cbranch_scc1 L_rr
  v_mov_b32 v8, 0
  s_mov_b32 s49, 0
L_fwait:
  s_sleep 1
  ds_read_b32 v9, v8 offset:17440
  s_add_u32 s49, s49, 1
  s_cmp_ge_u32 s49, 40000
  s_waitcnt lgkmcnt(0)
  v_cmp_eq_u32 vcc, 0, v9
  s_cbranch_scc1 L_fok
  s_cbranch_vccnz L_fwait
L_fok:
  buffer_load_dwordx4 v[40:43], v14, s[28:31], s53 offen
  buffer_load_dwordx4 v[44:47], v14, s[28:31], s53 offen offset:1024
  s_add_u32 s40, s40, 8
  s_cmp_eq_u32 s57, 1
  s_cbranch_scc1 L_lead
  s_sleep 28
  s_branch L_sp0
L_rr:
  buffer_load_dwordx4 v[40:43], v14, s[28:31], s53 offen
  buffer_load_dwordx4 v[44:47], v14, s[28:31], s53 offen offset:1024
L_sp0:
  s_mov_b32 s49, 0
  s_mov_b32 s46, s42
L_spoll:
  s_sleep 1
  s_load_dwordx16 s[76:91], s[18:19], s46
  s_add_u32 s46, s46, 64
  s_add_u32 s49, s49, 1
  s_cmp_gt_u32 s49, 31
  s_cbranch_scc1 L_ip0
  s_waitcnt lgkmcnt(0)
  s_xor_b32 s43, s77, s40
  s_xor_b32 s44, s79, s40
  s_or_b32 s43, s43, s44
  s_xor_b32 s44, s81, s40
  s_or_b32 s43, s43, s44
  s_xor_b32 s44, s83, s40
  s_or_b32 s43, s43, s44
  s_xor_b32 s44, s85, s40
  s_or_b32 s43, s43, s44
  s_xor_b32 s44, s87, s40
  s_or_b32 s43, s43, s44
  s_xor_b32 s44, s89, s40
  s_or_b32 s43, s43, s44
  s_xor_b32 s44, s91, s40
  s_or_b32 s43, s43, s44
  s_cbranch_scc1 L_spoll
  s_mov_b32 exec_lo, 0x01010101
  s_mov_b32 exec_hi, 0x01010101
  v_mov_b32 v6, s76
  s_lshl_b64 exec, exec, 1
  v_mov_b32 v6, s78
  s_lshl_b64 exec, exec, 1
  v_mov_b32 v6, s80
  s_lshl_b64 exec, exec, 1
  v_mov_b32 v6, s82
  s_lshl_b64 exec, exec, 1
  v_mov_b32 v6, s84
  s_lshl_b64 exec, exec, 1
  v_mov_b32 v6, s86
  s_lshl_b64 exec, exec, 1
  v_mov_b32 v6, s88
  s_lshl_b64 exec, exec, 1
  v_mov_b32 v6, s90
  s_mov_b64 exec, -1
  s_branch L_sok
L_lead:
  s_mov_b32 s49, 0
L_fw2:
  s_sleep 1
  ds_read_b32 v9, v8 offset:17444
  s_add_u32 s49, s49, 1
  s_cmp_ge_u32 s49, 40000
  s_waitcnt lgkmcnt(0)
  v_cmp_eq_u32 vcc, 0, v9
  s_cbranch_scc1 L_fo2
  s_cbranch_vccnz L_fw2
L_fo2:
L_ip0:
  s_waitcnt lgkmcnt(0)
  s_mov_b32 s49, 0
  s_branch L_ipl
L_ipoll:
  s_sleep 6
L_ipl:
  buffer_load_dwordx2 v[8:9], v12, s[32:35], s47 offen sc1
L_ichk:
  s_add_u32 s49, s49, 1
  s_cmp_ge_u32 s49, 40000
  s_waitcnt vmcnt(0)
  v_cmp_ne_u32 vcc, s40, v9
  s_cbranch_scc1 L_iok
  s_cbranch_vccnz L_ipoll
L_iok:
  v_max_u32_dpp v8, v8, v8 row_ror:8 row_mask:0xf bank_mask:0xf
  v_mov_b32 v9, v8
  v_mov_b32 v7, s40
  s_nop 0
  v_permlane16_swap_b32 v8, v9
  v_max_u32 v8, v8, v9
  v_mov_b32 v9, v8
  s_nop 1
  v_permlane32_swap_b32 v8, v9
  v_max_u32 v6, v8, v9
  buffer_store_dwordx2 v[6:7], v13, s[32:35], s42 offen offset:0
  buffer_store_dwordx2 v[6:7], v13, s[32:35], s42 offen offset:512
  buffer_store_dwordx2 v[6:7], v13, s[32:35], s42 offen offset:1024
  buffer_store_dwordx2 v[6:7], v13, s[32:35], s42 offen offset:1536
L_sok:
  s_mov_b32 m0, 0
  s_cmp_eq_u32 s57, 1
  v_and_b32 v10, 31, v6
  v_xor_b32 v10, 31, v10
  v_lshl_add_u32 v10, v4, 5, v10
  v_lshlrev_b32 v10, 11, v10
  v_lshl_add_u32 v10, v11, 4, v10
  buffer_load_dwordx4 v10, s[28:31], s45 offen lds
  s_mov_b32 m0, 1024
  v_add_u32 v10, 128, v10
  buffer_load_dwordx4 v10, s[28:31], s45 offen lds
  s_mov_b32 m0, 2048
  v_add_u32 v10, 128, v10
  buffer_load_dwordx4 v10, s[28:31], s45 offen lds
  s_mov_b32 m0, 3072
  v_add_u32 v10, 128, v10
  buffer_load_dwordx4 v10, s[28:31], s45 offen lds
  s_mov_b32 m0, 4096
  v_add_u32 v10, 128, v10
  s_cbranch_scc1 L_dmadone
  buffer_load_dwordx4 v10, s[28:31], s45 offen lds
  s_mov_b32 m0, 5120
  v_add_u32 v10, 128, v10
  buffer_load_dwordx4 v10, s[28:31], s45 offen lds
  s_mov_b32 m0, 6144
  v_add_u32 v10, 128, v10
  buffer_load_dwordx4 v10, s[28:31], s45 offen lds
  s_mov_b32 m0, 7168
  v_add_u32 v10, 128, v10
  buffer_load_dwordx4 v10, s[28:31], s45 offen lds
L_dmadone:
  buffer_load_dwordx4 v[24:27], v14, s[32:35], s48 offen
  buffer_load_dwordx4 v[28:31], v14, s[32:35], s48 offen offset:1024
  s_barrier
  v_readlane_b32 s55, v6, s51
  s_and_b32 s46, s2, 31
  s_and_b32 s54, s55, 31
  s_xor_b32 s54, s54, 31
  s_cmp_eq_u32 s54, s46
  s_cselect_b32 s56, 0x40000000, s53
  s_waitcnt vmcnt(10)
  s_cmp_eq_u32 s57, 0
  s_cbranch_scc1 L_idw
  s_waitcnt vmcnt(6)
L_idw:
  v_lshlrev_b32 v16, 16, v40
  v_and_b32 v17, 0xffff0000, v40
  v_pk_fma_f32 v[16:17], v[16:17], 0, v[16:17] op_sel_hi:[1,0,1]
  v_cvt_pk_bf16_f32 v40, v16, v17
  v_lshlrev_b32 v16, 16, v41
  v_and_b32 v17, 0xffff0000, v41
  v_pk_fma_f32 v[16:17], v[16:17], 0, v[16:17] op_sel_hi:[1,0,1]
  v_cvt_pk_bf16_f32 v41, v16, v17
  v_lshlrev_b32 v16, 16, v42
  v_and_b32 v17, 0xffff0000, v42
  v_pk_fma_f32 v[16:17], v[16:17], 0, v[16:17] op_sel_hi:[1,0,1]
  v_cvt_pk_bf16_f32 v42, v16, v17
  v_lshlrev_b32 v16, 16, v43
  v_and_b32 v17, 0xffff0000, v43
  v_pk_fma_f32 v[16:17], v[16:17], 0, v[16:17] op_sel_hi:[1,0,1]
  v_cvt_pk_bf16_f32 v43, v16, v17
  v_lshlrev_b32 v16, 16, v44
  v_and_b32 v17, 0xffff0000, v44
  v_pk_fma_f32 v[16:17], v[16:17], 0, v[16:17] op_sel_hi:[1,0,1]
  v_cvt_pk_bf16_f32 v44, v16, v17
  v_lshlrev_b32 v16, 16, v45
  v_and_b32 v17, 0xffff0000, v45
  v_pk_fma_f32 v[16:17], v[16:17], 0, v[16:17] op_sel_hi:[1,0,1]
  v_cvt_pk_bf16_f32 v45, v16, v17
  v_lshlrev_b32 v16, 16, v46
  v_and_b32 v17, 0xffff0000, v46
  v_pk_fma_f32 v[16:17], v[16:17], 0, v[16:17] op_sel_hi:[1,0,1]
  v_cvt_pk_bf16_f32 v46, v16, v17
  v_lshlrev_b32 v16, 16, v47
  v_and_b32 v17, 0xffff0000, v47
  v_pk_fma_f32 v[16:17], v[16:17], 0, v[16:17] op_sel_hi:[1,0,1]
  v_cvt_pk_bf16_f32 v47, v16, v17
  buffer_store_dwordx4 v[40:43], v14, s[36:39], s56 offen sc1
  buffer_store_dwordx4 v[44:47], v14, s[36:39], s56 offen offset:1024 sc1
  v_lshrrev_b32 v7, 5, v0
  v_bfe_u32 v8, v0, 4, 1
  v_lshl_add_u32 v7, v8, 1, v7
  v_lshl_add_u32 v7, v4, 2, v7
  s_lshl_b32 s45, s51, 5
  s_add_u32 s45, s45, s54
  s_lshl_b32 s45, s45, 5
  s_add_u32 s45, s45, s46
  s_lshl_b32 s45, s45, 5
  v_add_u32 v7, s45, v7
  v_lshlrev_b32 v7, 1, v7
  buffer_load_ushort v9, v7, s[28:31], 0 offen
  s_waitcnt vmcnt(5)
  s_barrier
  s_lshr_b32 s44, s55, 16
  s_xor_b32 s45, s44, 0xffff
  s_and_b32 s44, s44, 0x7fff
  s_cmp_lt_i32 s55, 0
  s_cselect_b32 s44, s44, s45
  s_lshl_b32 s44, s44, 16
  v_mov_b32 v10, 0xbfb8aa3b
  v_mul_f32 v10, s44, v10
  v_exp_f32 v10, v10
  s_and_b32 s41, s40, 0xff
  v_add_f32 v10, 1.0, v10
  v_rcp_f32 v10, v10
  s_barrier
  v_cvt_pk_bf16_f32 v10, v10, v10
  v_and_b32 v10, 0xffff0000, v10
  s_mul_i32 s46, s2, 8192
  s_add_u32 s46, s46, 1048576
  s_add_u32 s47, s46, 4096
  s_mov_b32 s49, 0
  s_mov_b32 s44, 0x00ff00ff
  s_mov_b32 s45, 0x00ff00ff
  s_waitcnt vmcnt(0)
  v_lshlrev_b32 v9, 16, v9
  v_fma_f32 v9, v9, 0, v9
  s_barrier
  s_sleep 26
  s_branch L_x2poll
L_x2re:
  s_cmp_ge_u32 s49, 40000
  s_cbranch_scc1 L_x2ok
L_x2poll:
  buffer_load_dwordx4 v[32:35], v14, s[32:35], s46 offen offset:0 sc1
  buffer_load_dwordx4 v[36:39], v14, s[32:35], s46 offen offset:1024 sc1
  buffer_load_dwordx4 v[40:43], v14, s[32:35], s46 offen offset:2048 sc1
  buffer_load_dwordx4 v[44:47], v14, s[32:35], s46 offen offset:3072 sc1
  buffer_load_dwordx4 v[48:51], v14, s[32:35], s47 offen offset:0 sc1
  buffer_load_dwordx4 v[52:55], v14, s[32:35], s47 offen offset:1024 sc1
  buffer_load_dwordx4 v[56:59], v14, s[32:35], s47 offen offset:2048 sc1
  s_add_u32 s49, s49, 1
  s_waitcnt vmcnt(6)
  v_xor_b32 v32, s41, v32
  v_xor_b32 v34, s41, v34
  v_or_b32 v15, v32, v34
  s_waitcnt vmcnt(5)
  v_xor_b32 v36, s41, v36
  v_xor_b32 v38, s41, v38
  v_or3_b32 v15, v15, v36, v38
  v_pk_add_f32 v[16:17], v[32:33], v[36:37]
  v_pk_add_f32 v[18:19], v[34:35], v[38:39]
  s_waitcnt vmcnt(4)
  v_xor_b32 v40, s41, v40
  v_xor_b32 v42, s41, v42
  v_or3_b32 v15, v15, v40, v42
  v_pk_add_f32 v[16:17], v[16:17], v[40:41]
  v_pk_add_f32 v[18:19], v[18:19], v[42:43]
  s_waitcnt vmcnt(3)
  v_xor_b32 v44, s41, v44
  v_xor_b32 v46, s41, v46
  v_or3_b32 v15, v15, v44, v46
  v_pk_add_f32 v[16:17], v[16:17], v[44:45]
  v_pk_add_f32 v[18:19], v[18:19], v[46:47]
  s_waitcnt vmcnt(2)
  v_xor_b32 v48, s41, v48
  v_xor_b32 v50, s41, v50
  v_or3_b32 v15, v15, v48, v50
  v_pk_add_f32 v[16:17], v[16:17], v[48:49]
  v_pk_add_f32 v[18:19], v[18:19], v[50:51]
  s_waitcnt vmcnt(1)
  v_xor_b32 v52, s41, v52
  v_xor_b32 v54, s41, v54
  v_or3_b32 v15, v15, v52, v54
  v_pk_add_f32 v[16:17], v[16:17], v[52:53]
  v_pk_add_f32 v[18:19], v[18:19], v[54:55]
  s_waitcnt vmcnt(0)
  v_xor_b32 v56, s41, v56
  v_xor_b32 v58, s41, v58
  v_or3_b32 v15, v15, v56, v58
  v_pk_add_f32 v[16:17], v[16:17], v[56:57]
  v_pk_add_f32 v[18:19], v[18:19], v[58:59]
  v_cmp_ne_u32_sdwa vcc, v15, 0 src0_sel:BYTE_0 src1_sel:DWORD
  s_cbranch_vccnz L_x2re
L_x2ok:
  v_permlane32_swap_b32 v16, v17
  v_permlane32_swap_b32 v18, v19
  v_add_f32 v16, v16, v17
  v_add_f32 v18, v18, v19
  s_nop 1
  v_permlane16_swap_b32 v16, v18
  v_add_f32 v16, v16, v18
  s_nop 1
  v_add_f32_dpp v16, v16, v16 row_ror:8 row_mask:0xf bank_mask:0xf
  s_mov_b64 exec, s[44:45]
  v_cvt_pk_bf16_f32 v16, 0, v16
  v_mul_f32 v16, v16, v10
  v_cvt_pk_bf16_f32 v16, 0, v16
  v_add_f32 v16, v9, v16
  v_cvt_pk_bf16_f32 v16, v16, v16
  buffer_store_short v16, v7, s[36:39], 0 offen
  s_cmp_lg_u32 s2, 193
  s_cbranch_scc1 L_noep
  v_mov_b32 v18, s40
  s_mov_b64 exec, 1
  buffer_store_dword v18, off, s[32:35], 0
L_noep:
L_fin:
L_end:
  s_endpgm
L_x1noa:
  v_lshlrev_b32 v8, 1, v6
  s_lshl_b32 s56, s20, 15
  s_add_u32 s56, s56, 3145728
  s_cmp_lg_u32 s49, 12
  s_cbranch_scc1 L_x1nsa
  v_and_b32 v96, s48, v16
  v_mov_b32 v97, v17
  v_mov_b32 v98, s40
  v_mov_b32 v99, s40
  s_lshl_b32 s47, s21, 12
  s_add_u32 s47, s47, s56
  buffer_store_dwordx4 v[96:99], v8, s[32:35], s47 offen sc1
  s_waitcnt vmcnt(0)
L_x1nsa:
  s_lshl_b32 s47, s21, 12
  s_add_u32 s56, s56, s47
  s_xor_b32 s47, s56, 0
  buffer_load_dwordx4 v[96:99], v8, s[32:35], s47 offen sc1
  s_xor_b32 s47, s56, 4096
  buffer_load_dwordx4 v[100:103], v8, s[32:35], s47 offen sc1
  s_xor_b32 s47, s56, 8192
  buffer_load_dwordx4 v[104:107], v8, s[32:35], s47 offen sc1
  s_xor_b32 s47, s56, 12288
  buffer_load_dwordx4 v[108:111], v8, s[32:35], s47 offen sc1
  s_waitcnt vmcnt(0)
  v_mov_b32 v8, 0
  v_xor_b32 v98, s40, v98
  v_xor_b32 v99, s40, v99
  v_or3_b32 v8, v8, v98, v99
  v_mov_b32 v24, v96
  v_mov_b32 v25, v97
  v_xor_b32 v102, s40, v102
  v_xor_b32 v103, s40, v103
  v_or3_b32 v8, v8, v102, v103
  v_mov_b32 v26, v100
  v_mov_b32 v27, v101
  v_xor_b32 v106, s40, v106
  v_xor_b32 v107, s40, v107
  v_or3_b32 v8, v8, v106, v107
  v_mov_b32 v28, v104
  v_mov_b32 v29, v105
  v_xor_b32 v110, s40, v110
  v_xor_b32 v111, s40, v111
  v_or3_b32 v8, v8, v110, v111
  v_mov_b32 v30, v108
  v_mov_b32 v31, v109
  v_cmp_ne_u32 vcc, 0, v8
  s_cbranch_vccz L_x1oka
  s_cmp_lt_u32 s49, 40000
  s_cbranch_scc1 L_x1polla
  s_branch L_x1oka
L_x1nob:
  v_lshlrev_b32 v8, 1, v6
  s_lshl_b32 s56, s20, 15
  s_add_u32 s56, s56, 3145728
  s_cmp_lg_u32 s49, 12
  s_cbranch_scc1 L_x1nsb
  v_and_b32 v96, s48, v16
  v_mov_b32 v97, v17
  v_mov_b32 v98, s40
  v_mov_b32 v99, s40
  s_lshl_b32 s47, s21, 12
  s_add_u32 s47, s47, s56
  buffer_store_dwordx4 v[96:99], v8, s[32:35], s47 offen sc1
  s_waitcnt vmcnt(0)
L_x1nsb:
  s_lshl_b32 s47, s21, 12
  s_add_u32 s56, s56, s47
  s_xor_b32 s47, s56, 0
  buffer_load_dwordx4 v[96:99], v8, s[32:35], s47 offen sc1
  s_xor_b32 s47, s56, 4096
  buffer_load_dwordx4 v[100:103], v8, s[32:35], s47 offen sc1
  s_xor_b32 s47, s56, 8192
  buffer_load_dwordx4 v[104:107], v8, s[32:35], s47 offen sc1
  s_xor_b32 s47, s56, 12288
  buffer_load_dwordx4 v[108:111], v8, s[32:35], s47 offen sc1
  s_xor_b32 s47, s56, 16384
  buffer_load_dwordx4 v[112:115], v8, s[32:35], s47 offen sc1
  s_xor_b32 s47, s56, 20480
  buffer_load_dwordx4 v[116:119], v8, s[32:35], s47 offen sc1
  s_xor_b32 s47, s56, 24576
  buffer_load_dwordx4 v[120:123], v8, s[32:35], s47 offen sc1
  s_xor_b32 s47, s56, 28672
  buffer_load_dwordx4 v[124:127], v8, s[32:35], s47 offen sc1
  s_waitcnt vmcnt(0)
  v_mov_b32 v8, 0
  v_xor_b32 v98, s40, v98
  v_xor_b32 v99, s40, v99
  v_or3_b32 v8, v8, v98, v99
  v_mov_b32 v24, v96
  v_mov_b32 v25, v97
  v_xor_b32 v102, s40, v102
  v_xor_b32 v103, s40, v103
  v_or3_b32 v8, v8, v102, v103
  v_mov_b32 v26, v100
  v_mov_b32 v27, v101
  v_xor_b32 v106, s40, v106
  v_xor_b32 v107, s40, v107
  v_or3_b32 v8, v8, v106, v107
  v_mov_b32 v28, v104
  v_mov_b32 v29, v105
  v_xor_b32 v110, s40, v110
  v_xor_b32 v111, s40, v111
  v_or3_b32 v8, v8, v110, v111
  v_mov_b32 v30, v108
  v_mov_b32 v31, v109
  v_xor_b32 v114, s40, v114
  v_xor_b32 v115, s40, v115
  v_or3_b32 v8, v8, v114, v115
  v_mov_b32 v32, v112
  v_mov_b32 v33, v113
  v_xor_b32 v118, s40, v118
  v_xor_b32 v119, s40, v119
  v_or3_b32 v8, v8, v118, v119
  v_mov_b32 v34, v116
  v_mov_b32 v35, v117
  v_xor_b32 v122, s40, v122
  v_xor_b32 v123, s40, v123
  v_or3_b32 v8, v8, v122, v123
  v_mov_b32 v36, v120
  v_mov_b32 v37, v121
  v_xor_b32 v126, s40, v126
  v_xor_b32 v127, s40, v127
  v_or3_b32 v8, v8, v126, v127
  v_mov_b32 v38, v124
  v_mov_b32 v39, v125
  v_cmp_ne_u32 vcc, 0, v8
  s_cbranch_vccz L_x1okb
  s_cmp_lt_u32 s49, 40000
  s_cbranch_scc1 L_x1pollb
  s_branch L_x1okb
.section .rodata,"a"
.p2align 6
.amdhsa_kernel standalone__moe_arch_mod__sampling_kernel
  .amdhsa_next_free_vgpr 160
  .amdhsa_next_free_sgpr 96
  .amdhsa_accum_offset 160
  .amdhsa_group_segment_fixed_size 0
  .amdhsa_kernarg_size 64
  .amdhsa_user_sgpr_count 2
  .amdhsa_user_sgpr_kernarg_segment_ptr 1
  .amdhsa_system_sgpr_workgroup_id_x 1
  .amdhsa_float_denorm_mode_32 3
.end_amdhsa_kernel
```
